```python
import torch

def _softmax(x, axis=-1):
    return torch.softmax(x, dim=axis)
def _gelu(x):
    return torch.nn.functional.gelu(x, approximate="tanh")
def _silu(x):
    return torch.nn.functional.silu(x)
def _sigmoid(x):
    return torch.sigmoid(x)
def _layernorm(x, axis=-1, eps=1e-5):
    m = x.mean(dim=axis, keepdim=True)
    v = x.var(dim=axis, keepdim=True, unbiased=False)
    return (x - m) / torch.sqrt(v + eps)
def _scatter_add(tgt, idx, src, axis=0):
    return tgt.clone().index_add_(axis, idx, src)
def _segment_sum(src, seg, n):
    out = torch.zeros((n,) + src.shape[1:], dtype=src.dtype)
    return out.index_add_(0, seg, src)
def _pad(x, pw):
    flat = tuple(v for pair in reversed(pw) for v in pair)
    return torch.nn.functional.pad(x, flat)

kernel_name = 'standalone__grn__sampling'

def setup_inputs():

    _w = (lambda a: (lambda t: t.to(torch.bfloat16) if t.is_floating_point() else t)(torch.as_tensor(a)))
    B, S, D = 1024, 8, 640
    return {
        "x": _w((lambda *s: torch.randn(*s, dtype=torch.bfloat16) * 0.05)(B, S, D)),
        "g": _w((lambda *s: torch.randn(*s, dtype=torch.bfloat16) * 0.4)(D) * 0.1),
        "b": _w((lambda *s: torch.randn(*s, dtype=torch.bfloat16) * 0.1)(D) * 0.1),
    }

def reference(x, g, b):
    gx = torch.sqrt((x * x).sum(axis=-2, keepdims=True))
    nx = gx / (gx.mean(axis=-1, keepdims=True) + 1e-6)
    return g * (x * nx) + b + x
```

```asm
; @launch grid=(256,1,1) block=(320,1,1) lds=0
.amdgcn_target "amdgcn-amd-amdhsa--gfx950"
.text
.globl standalone__grn__sampling_kernel
.p2align 12
.p2align 8
.type standalone__grn__sampling_kernel,@function

.macro UNPACK2 d, s
    v_lshlrev_b32 v[\d], 16, v[\s]
    v_and_b32 v[\d+1], s29, v[\s]
.endm
.macro UNPACK8 d, s
    UNPACK2 \d, \s
    UNPACK2 \d+2, \s+1
    UNPACK2 \d+4, \s+2
    UNPACK2 \d+6, \s+3
.endm
.macro PKMUL4 d, a, b
    v_pk_mul_f32 v[\d:\d+1], v[\a:\a+1], v[\b:\b+1]
    v_pk_mul_f32 v[\d+2:\d+3], v[\a+2:\a+3], v[\b+2:\b+3]
    v_pk_mul_f32 v[\d+4:\d+5], v[\a+4:\a+5], v[\b+4:\b+5]
    v_pk_mul_f32 v[\d+6:\d+7], v[\a+6:\a+7], v[\b+6:\b+7]
.endm
.macro PKFMA4 d, a, b, c
    v_pk_fma_f32 v[\d:\d+1], v[\a:\a+1], v[\b:\b+1], v[\c:\c+1]
    v_pk_fma_f32 v[\d+2:\d+3], v[\a+2:\a+3], v[\b+2:\b+3], v[\c+2:\c+3]
    v_pk_fma_f32 v[\d+4:\d+5], v[\a+4:\a+5], v[\b+4:\b+5], v[\c+4:\c+5]
    v_pk_fma_f32 v[\d+6:\d+7], v[\a+6:\a+7], v[\b+6:\b+7], v[\c+6:\c+7]
.endm
.macro ROWIN n, d, s
    s_waitcnt vmcnt(\n)
    v_lshlrev_b32 v[\d], 16, v[\s]
    v_and_b32_e64 v[\d+1], s29, v[\s]
    UNPACK2 \d+2, \s+1
    UNPACK2 \d+4, \s+2
    UNPACK2 \d+6, \s+3
.endm
.macro COEF d
    v_pk_fma_f32 v[\d:\d+1], v[\d:\d+1], s[20:21], 1.0 op_sel_hi:[1,0,0]
    v_pk_fma_f32 v[\d+2:\d+3], v[\d+2:\d+3], s[20:21], 1.0 op_sel_hi:[1,0,0]
    v_pk_fma_f32 v[\d+4:\d+5], v[\d+4:\d+5], s[20:21], 1.0 op_sel_hi:[1,0,0]
    v_pk_fma_f32 v[\d+6:\d+7], v[\d+6:\d+7], s[20:21], 1.0 op_sel_hi:[1,0,0]
.endm
.macro OUT8 u, c, b
    PKFMA4 \u, \u, \c, \b
    v_cvt_pk_bf16_f32 v[\u], v[\u], v[\u+1]
    v_cvt_pk_bf16_f32 v[\u+1], v[\u+2], v[\u+3]
    v_cvt_pk_bf16_f32 v[\u+2], v[\u+4], v[\u+5]
    v_cvt_pk_bf16_f32 v[\u+3], v[\u+6], v[\u+7]
.endm

standalone__grn__sampling_kernel:
    s_load_dwordx8 s[4:11], s[0:1], 0
    s_cmp_lt_u32 s2, 256
    s_cbranch_scc0 L_done
    v_lshrrev_b32 v4, 6, v0
    v_lshlrev_b32 v5, 4, v0
    v_and_b32 v6, 0xf0, v5
    v_and_b32 v5, 0x3f0, v5
    v_readfirstlane_b32 s31, v4
    v_bfe_u32 v7, v0, 4, 2
    s_lshl_b32 s3, s2, 2
    s_add_u32 s3, s3, s31
    s_mul_i32 s3, s3, 10240
    s_add_u32 s28, s3, 3840
    s_add_u32 s30, s3, 8960
    s_add_u32 s3, s3, 3584
    v_mul_u32_u24 v7, 1280, v7
    v_add_u32 v2, s28, v5
    v_add_u32 v3, s30, v5
    v_add3_u32 v4, s3, v6, v7
    s_mov_b32 s29, 0xffff0000
    s_mov_b64 vcc, -1
    s_cmp_eq_u32 s31, 4
    s_cbranch_scc1 L_touch
    s_mov_b64 vcc, 0
    s_cmp_lg_u32 s31, 3
    s_waitcnt lgkmcnt(0)
    global_load_dwordx4 v[40:43], v4, s[4:5] offset:-2560 nt
    global_load_dwordx4 v[44:47], v4, s[4:5] offset:2560 nt
    global_load_dwordx4 v[48:51], v5, s[6:7]
    global_load_dwordx4 v[52:55], v5, s[8:9]
    global_load_dwordx4 v[56:59], v6, s[6:7] offset:1024
    global_load_dwordx4 v[60:63], v6, s[8:9] offset:1024
    s_cbranch_scc1 L_main
    s_barrier
L_main:
    global_load_dwordx4 v[8:11], v2, s[4:5] offset:-3840 nt
    global_load_dwordx4 v[12:15], v2, s[4:5] offset:-2560 nt
    global_load_dwordx4 v[16:19], v2, s[4:5] offset:-1280 nt
    global_load_dwordx4 v[20:23], v2, s[4:5] nt
    global_load_dwordx4 v[24:27], v2, s[4:5] offset:1280 nt
    global_load_dwordx4 v[28:31], v2, s[4:5] offset:2560 nt
    global_load_dwordx4 v[32:35], v2, s[4:5] offset:3840 nt
    global_load_dwordx4 v[36:39], v3, s[4:5] nt
    s_barrier
    s_cbranch_scc0 L_issued
    s_barrier
L_issued:
    global_load_dword v1, v6, s[6:7]

    s_waitcnt vmcnt(13)
    UNPACK8 144, 40
    UNPACK8 152, 44
    PKMUL4 72, 144, 144
    PKFMA4 72, 152, 152, 72
    s_nop 1
    v_permlane32_swap_b32 v72, v76
    v_permlane32_swap_b32 v73, v77
    v_permlane32_swap_b32 v74, v78
    v_permlane32_swap_b32 v75, v79
    v_pk_add_f32 v[72:73], v[72:73], v[76:77]
    v_pk_add_f32 v[74:75], v[74:75], v[78:79]
    s_nop 1
    v_permlane16_swap_b32 v72, v74
    v_permlane16_swap_b32 v73, v75
    v_pk_add_f32 v[72:73], v[72:73], v[74:75]
    v_sqrt_f32 v6, v72
    v_sqrt_f32 v7, v73
    v_mov_b32 v5, 0x358637bd
    v_mov_b32 v72, v6
    v_mov_b32 v73, v7
    v_mov_b32 v74, v6
    v_mov_b32 v75, v7
    s_nop 1
    v_permlane16_swap_b32 v72, v74
    v_permlane16_swap_b32 v73, v75
    v_mov_b32 v76, v72
    v_mov_b32 v77, v73
    v_mov_b32 v78, v74
    v_mov_b32 v79, v75
    s_nop 1
    v_permlane32_swap_b32 v72, v76
    v_permlane32_swap_b32 v73, v77
    v_permlane32_swap_b32 v74, v78
    v_permlane32_swap_b32 v75, v79
    s_waitcnt vmcnt(9)
    UNPACK8 160, 48
    UNPACK8 168, 52
    UNPACK8 176, 56
    UNPACK8 184, 60
    PKMUL4 72, 72, 176
    .p2align 3
    ROWIN 8, 80, 8
    PKMUL4 64, 80, 80
    ROWIN 7, 88, 12
    PKFMA4 64, 88, 88, 64
    ROWIN 6, 96, 16
    PKFMA4 64, 96, 96, 64
    ROWIN 5, 104, 20
    PKFMA4 64, 104, 104, 64
    ROWIN 4, 112, 24
    PKFMA4 64, 112, 112, 64
    ROWIN 3, 120, 28
    PKFMA4 64, 120, 120, 64
    ROWIN 2, 128, 32
    PKFMA4 64, 128, 128, 64
L_touch:
    s_cbranch_vccnz L_done
    s_waitcnt vmcnt(1)
    UNPACK8 136, 36
    PKFMA4 64, 136, 136, 64
    v_sqrt_f32 v64, v64
    v_sqrt_f32 v65, v65
    v_sqrt_f32 v66, v66
    v_sqrt_f32 v67, v67
    v_sqrt_f32 v68, v68
    v_sqrt_f32 v69, v69
    v_sqrt_f32 v70, v70
    v_sqrt_f32 v71, v71
    v_pk_add_f32 v[6:7], v[6:7], v[64:65]
    v_pk_add_f32 v[8:9], v[66:67], v[68:69]
    v_pk_add_f32 v[6:7], v[6:7], v[70:71]
    v_pk_add_f32 v[6:7], v[6:7], v[8:9]
    v_add_f32_e64 v6, v6, v7
    v_pk_mul_f32 v[64:65], v[64:65], v[160:161]
    v_pk_mul_f32 v[66:67], v[66:67], v[162:163]
    v_add_f32_dpp v6, v6, v6 row_ror:8 row_mask:0xf bank_mask:0xf
    v_pk_mul_f32 v[68:69], v[68:69], v[164:165]
    v_pk_mul_f32 v[70:71], v[70:71], v[166:167]
    v_add_f32_dpp v6, v6, v6 row_ror:4 row_mask:0xf bank_mask:0xf
    s_nop 1
    v_add_f32_dpp v6, v6, v6 row_ror:2 row_mask:0xf bank_mask:0xf
    s_nop 1
    v_add_f32_dpp v6, v6, v6 row_ror:1 row_mask:0xf bank_mask:0xf
    s_nop 1
    v_add_f32_dpp v6, v6, v6 row_bcast:15 row_mask:0xa bank_mask:0xf
    s_nop 1
    v_add_f32_dpp v6, v6, v6 row_bcast:31 row_mask:0xc bank_mask:0xf
    v_fmac_f32 v5, 0x3acccccd, v6
    v_rcp_f32 v5, v5
    s_nop 0
    v_readlane_b32 s20, v5, 63
    s_nop 0
    s_nop 0
    .p2align 3
    COEF 64
    OUT8 80, 64, 168
    s_waitcnt vmcnt(0)
    .p2align 3
    global_store_dwordx4 v2, v[80:83], s[10:11] offset:-3840 nt
    OUT8 88, 64, 168
    global_store_dwordx4 v2, v[88:91], s[10:11] offset:-2560 nt
    OUT8 96, 64, 168
    global_store_dwordx4 v2, v[96:99], s[10:11] offset:-1280 nt
    OUT8 104, 64, 168
    global_store_dwordx4 v2, v[104:107], s[10:11] nt
    OUT8 112, 64, 168
    global_store_dwordx4 v2, v[112:115], s[10:11] offset:1280 nt
    OUT8 120, 64, 168
    global_store_dwordx4 v2, v[120:123], s[10:11] offset:2560 nt
    OUT8 128, 64, 168
    global_store_dwordx4 v2, v[128:131], s[10:11] offset:3840 nt
    OUT8 136, 64, 168
    global_store_dwordx4 v3, v[136:139], s[10:11] nt
    COEF 72
    OUT8 144, 72, 184
    global_store_dwordx4 v4, v[144:147], s[10:11] offset:-2560 nt
    OUT8 152, 72, 184
    global_store_dwordx4 v4, v[152:155], s[10:11] offset:2560 nt
L_done:
    s_endpgm
.section .rodata,"a"
.p2align 6
.amdhsa_kernel standalone__grn__sampling_kernel
  .amdhsa_next_free_vgpr 192
  .amdhsa_next_free_sgpr 32
  .amdhsa_accum_offset 192
  .amdhsa_group_segment_fixed_size 0
  .amdhsa_kernarg_size 48
  .amdhsa_user_sgpr_count 2
  .amdhsa_user_sgpr_kernarg_segment_ptr 1
  .amdhsa_system_sgpr_workgroup_id_x 1
  .amdhsa_float_denorm_mode_32 3
.end_amdhsa_kernel
```
